```python
import torch

def _softmax(x, axis=-1):
    return torch.softmax(x, dim=axis)
def _gelu(x):
    return torch.nn.functional.gelu(x, approximate="tanh")
def _silu(x):
    return torch.nn.functional.silu(x)
def _sigmoid(x):
    return torch.sigmoid(x)
def _layernorm(x, axis=-1, eps=1e-5):
    m = x.mean(dim=axis, keepdim=True)
    v = x.var(dim=axis, keepdim=True, unbiased=False)
    return (x - m) / torch.sqrt(v + eps)
def _scatter_add(tgt, idx, src, axis=0):
    return tgt.clone().index_add_(axis, idx, src)
def _segment_sum(src, seg, n):
    out = torch.zeros((n,) + src.shape[1:], dtype=src.dtype)
    return out.index_add_(0, seg, src)
def _pad(x, pw):
    flat = tuple(v for pair in reversed(pw) for v in pair)
    return torch.nn.functional.pad(x, flat)

kernel_name = 'standalone__sequential_behavior_din__recsys'

def setup_inputs():

    _w = (lambda a: (lambda t: t.to(torch.bfloat16) if t.is_floating_point() else t)(torch.as_tensor(a)))
    B, L, D = 4096, 200, 32
    H = D
    return {
        "target": _w((lambda *s: torch.randn(*s, dtype=torch.bfloat16) * 1.6)(B, D)),
        "hist": _w((lambda *s: torch.randn(*s, dtype=torch.bfloat16) * 1.6)(B, L, D)),
        "mask": _w((lambda lo, hi, *s: torch.randint(lo, hi, s))(0, 2, B, L).to(float)),
        "w1": _w((lambda *s: torch.randn(*s, dtype=torch.bfloat16) * 1.6)(4 * D, H) * (4 * D) ** -0.5),
        "b1": _w((lambda *s: torch.randn(*s, dtype=torch.bfloat16) * 6.4)(H) * 0.1),
        "w2": _w((lambda *s: torch.randn(*s, dtype=torch.bfloat16) * 0.05)(H, 1) * H ** -0.5),
        "b2": _w((lambda *s: torch.randn(*s, dtype=torch.bfloat16) * 0.4)(1) * 0.1),
    }

def reference(target, hist, mask, w1, b1, w2, b2):
    L = hist.shape[1]
    tgt = (lambda x, n, axis: torch.repeat_interleave(x, n, dim=axis))(target[:, None, :], L, axis=1)
    feat = torch.concatenate([hist, tgt, hist - tgt, hist * tgt], axis=-1)
    h = _sigmoid(feat @ w1 + b1)
    scores = (h @ w2 + b2)[..., 0] * mask
    return torch.einsum('bl,bld->bd', scores, hist)
```

```asm
; @launch grid=(256,1,1) block=(1024,1,1) lds=63616
.amdgcn_target "amdgcn-amd-amdhsa--gfx950"
.text
.globl standalone__sequential_behavior_din__recsys_kernel
.p2align 8
.type standalone__sequential_behavior_din__recsys_kernel,@function
standalone__sequential_behavior_din__recsys_kernel:
    s_cmp_ge_u32 s2, 256
    s_cbranch_scc1 L_end
    s_load_dwordx16 s[4:19], s[0:1], 0
    s_setprio 3
    v_lshrrev_b32 v3, 6, v0
    v_and_b32 v1, 63, v0
    v_readfirstlane_b32 s3, v3
    v_lshlrev_b32 v8, 3, v1
    s_lshl_b32 s36, s2, 4
    s_add_u32 s36, s36, s3
    s_lshr_b32 s37, s3, 1
    s_and_b32 s38, s3, 1
    s_lshl_b32 s37, s37, 8
    s_lshl_b32 s38, s38, 5
    v_lshrrev_b32 v3, 3, v1
    s_add_u32 s37, s37, s38
    v_bfe_u32 v4, v1, 1, 2
    v_lshlrev_b32 v4, 6, v4
    v_lshl_add_u32 v3, v3, 11, v4
    v_and_b32 v4, 1, v1
    v_lshl_add_u32 v3, v4, 4, v3
    v_add_u32 v3, s37, v3
    v_and_b32 v4, 3, v1
    v_lshlrev_b32 v4, 4, v4
    v_cmp_gt_u32 vcc, 32, v1
    s_mul_i32 s37, s36, 400
    s_mul_i32 s38, s36, 12800
    v_cndmask_b32 v15, v4, v3, vcc
    s_mul_i32 s56, s3, 768
    s_add_u32 s56, s56, 38912
    s_lshl_b32 s52, s36, 6
    s_mov_b32 s26, 400
    s_mov_b32 s27, 0x00020000
    s_mov_b32 m0, s56
    s_waitcnt lgkmcnt(0)
    s_add_u32 s24, s8, s37
    s_addc_u32 s25, s9, 0
    s_add_u32 s4, s4, s52
    s_addc_u32 s5, s5, 0
    buffer_load_dwordx2 v[6:7], v8, s[24:27], 0 offen nt
    s_load_dword s39, s[16:17], 0
    v_mov_b32 v16, s10
    v_mov_b32 v17, s11
    s_mov_b32 exec_lo, 0
    s_mov_b32 exec_hi, 0xf
    v_mov_b32 v16, s4
    v_mov_b32 v17, s5
    s_mov_b32 exec_hi, 0xf0
    v_mov_b32 v16, s14
    v_mov_b32 v17, s15
    s_mov_b32 exec_hi, 0xf00
    v_mov_b32 v16, s12
    v_mov_b32 v17, s13
    s_mov_b32 exec_lo, -1
    s_cmp_eq_u32 s3, 0
    s_cselect_b32 exec_hi, 0xfff, 0xf
    v_add_co_u32 v16, vcc, v16, v15
    s_add_u32 s20, s6, s38
    s_addc_u32 s21, s7, 0
    v_addc_co_u32 v17, vcc, 0, v17, vcc
    s_add_u32 s32, s18, s52
    s_addc_u32 s33, s19, 0
    global_load_lds_dwordx4 v[16:17], off
    s_mov_b64 exec, -1
    s_setprio 0
    s_mov_b32 s22, 12800
    s_mov_b32 s23, 0x00020000
    s_mov_b32 s34, 64
    s_mov_b32 s35, 0x00020000
    s_lshl_b32 s54, s3, 10
    s_mul_i32 s55, s3, 1408
    s_add_u32 s55, s55, 16384
    s_mov_b32 s57, 0xbfb8aa3b
    s_mov_b32 s72, 0x3f80
    s_mov_b32 s58, 0xffff
    s_mov_b32 s59, 0
    v_lshrrev_b32 v2, 4, v1
    v_lshlrev_b32 v5, 1, v1
    v_mov_b32 v64, 0
    v_mov_b32 v65, 0
    v_mov_b32 v66, 0
    v_mov_b32 v67, 0
    v_mov_b32 v68, 0
    v_add_u32 v4, s55, v8
    v_mov_b32 v40, -1
    v_mov_b32 v41, -1
    ds_write_b64 v4, v[40:41] offset:896
    s_add_u32 s37, s55, 896
    v_mov_b32 v18, s37
    v_and_b32 v3, 3, v1
    v_lshrrev_b32 v4, 2, v1
    v_lshlrev_b32 v33, 1, v3
    v_lshl_or_b32 v33, v4, 4, v33
    v_lshlrev_b32 v4, 1, v4
    v_lshl_or_b32 v3, v3, 5, v4
    v_add_u32 v19, s56, v3
    v_lshlrev_b32 v10, 2, v1
    v_add_u32 v11, 1, v10
    v_add_u32 v12, 2, v10
    v_add_u32 v13, 3, v10
    v_lshlrev_b32 v35, 4, v2
    v_and_b32 v3, 15, v1
    v_add_u32 v34, s55, v3
    v_bfe_u32 v4, v1, 1, 2
    v_xor_b32 v4, v4, v2
    v_lshlrev_b32 v4, 4, v4
    v_lshl_or_b32 v4, v3, 6, v4
    v_add_u32 v36, s54, v4
    v_lshrrev_b32 v3, 2, v1
    v_bfe_u32 v4, v1, 3, 2
    v_bfe_u32 v38, v1, 1, 1
    v_xor_b32 v4, v4, v38
    v_lshlrev_b32 v4, 4, v4
    v_lshl_or_b32 v4, v3, 6, v4
    v_and_b32 v3, 1, v1
    v_lshl_or_b32 v4, v3, 3, v4
    v_add_u32 v37, s54, v4
    v_xor_b32 v4, 32, v4
    v_add_u32 v38, s54, v4
    s_and_b32 s37, s3, 1
    s_lshl_b32 s37, s37, 11
    s_lshr_b32 s38, s3, 2
    s_lshl_b32 s38, s38, 8
    s_add_u32 s37, s37, s38
    s_bfe_u32 s38, s3, 0x10001
    s_lshl_b32 s48, s38, 10
    s_add_u32 s48, s48, s37
    s_add_u32 s48, s48, 51200
    v_lshl_add_u32 v32, v1, 2, s48
    s_lshl_b32 s38, s38, 3
    s_add_u32 s37, s37, s38
    s_add_u32 s37, s37, 59392
    v_add_u32 v33, s37, v33
    v_mov_b32 v56, 0
    v_mov_b32 v60, 0
    v_mov_b32 v104, 0
    v_mov_b32 v108, 0
    v_mov_b32 v57, 0
    v_mov_b32 v61, 0
    v_mov_b32 v105, 0
    v_mov_b32 v109, 0
    v_mov_b32 v58, 0
    v_mov_b32 v62, 0
    v_mov_b32 v106, 0
    v_mov_b32 v110, 0
    v_mov_b32 v59, 0
    v_mov_b32 v63, 0
    v_mov_b32 v107, 0
    v_mov_b32 v111, 0
    v_and_b32 v3, 62, v5
    v_add_u32 v9, s56, v3
    v_lshlrev_b32 v8, 1, v3
    v_add_u32 v8, 63488, v8
    v_lshl_add_u32 v14, v2, 4, s56
    v_lshlrev_b32 v15, 4, v1
    v_add_u32 v15, 51200, v15
    v_add_u32 v16, 63488, v35
    v_lshlrev_b32 v17, 3, v2
    v_add_u32 v17, 39488, v17
    s_setprio 2
    s_waitcnt vmcnt(1)
    v_cmp_ne_u32_sdwa s[40:41], v6, 0 src0_sel:WORD_0 src1_sel:DWORD
    v_cmp_ne_u32_sdwa s[42:43], v6, 0 src0_sel:WORD_1 src1_sel:DWORD
    v_cmp_ne_u32_sdwa s[44:45], v7, 0 src0_sel:WORD_0 src1_sel:DWORD
    v_cmp_ne_u32_sdwa s[46:47], v7, 0 src0_sel:WORD_1 src1_sel:DWORD
    v_mbcnt_lo_u32_b32 v40, s40, v18
    s_bcnt1_i32_b64 s48, s[40:41]
    v_mbcnt_hi_u32_b32 v40, s41, v40
    s_bcnt1_i32_b64 s49, s[42:43]
    v_mbcnt_lo_u32_b32 v40, s42, v40
    v_mbcnt_hi_u32_b32 v40, s43, v40
    s_bcnt1_i32_b64 s50, s[44:45]
    v_mbcnt_lo_u32_b32 v40, s44, v40
    v_mbcnt_hi_u32_b32 v40, s45, v40
    s_bcnt1_i32_b64 s51, s[46:47]
    v_mbcnt_lo_u32_b32 v40, s46, v40
    v_mbcnt_hi_u32_b32 v40, s47, v40
    v_addc_co_u32_e64 v41, s[60:61], v40, 0, s[40:41]
    v_addc_co_u32_e64 v42, s[60:61], v41, 0, s[42:43]
    v_addc_co_u32_e64 v43, s[60:61], v42, 0, s[44:45]
    s_mov_b64 exec, s[40:41]
    ds_write_b8 v40, v10
    s_mov_b64 exec, s[42:43]
    ds_write_b8 v41, v11
    s_mov_b64 exec, s[44:45]
    ds_write_b8 v42, v12
    s_mov_b64 exec, s[46:47]
    ds_write_b8 v43, v13
    s_mov_b64 exec, -1
    ds_read_u8 v52, v34 offset:896
    ds_read_u8 v53, v34 offset:912
    ds_read_u8 v54, v34 offset:928
    s_add_u32 s52, s48, s49
    s_add_u32 s37, s50, s51
    s_add_u32 s52, s52, s37
    s_add_u32 s53, s52, 15
    s_lshr_b32 s53, s53, 4
    s_mov_b32 s28, 0
    s_cmp_ge_u32 s3, 12
    s_cselect_b32 s28, 1, s28
    s_waitcnt lgkmcnt(0)
    v_lshl_or_b32 v52, v52, 6, v35
    buffer_load_dwordx4 v[112:115], v52, s[20:23], 0 offen nt
    s_setprio 0
    s_waitcnt vmcnt(1)
    ds_read_u16_d16_hi v64, v19 offset:0
    ds_read_u16_d16_hi v65, v19 offset:128
    ds_read_u16_d16_hi v66, v19 offset:256
    ds_read_u16_d16_hi v67, v19 offset:384
    ds_read_u16_d16_hi v68, v9 offset:640
    ds_read_b128 v[28:31], v14 offset:512
    v_lshl_or_b32 v53, v53, 6, v35
    v_lshl_or_b32 v54, v54, 6, v35
    s_waitcnt lgkmcnt(1)
    v_add_f32 v64, v64, v66
    v_sub_f32 v65, v65, v66
    v_mul_f32 v64, s57, v64
    v_mul_f32 v65, s57, v65
    v_mul_f32 v67, s57, v67
    ds_write_b32 v32, v64
    v_cvt_pk_bf16_f32 v66, v65, v65
    ds_write_b32 v32, v67 offset:4096
    v_lshlrev_b32 v3, 16, v66
    ds_write_b16 v33, v66
    v_sub_f32 v3, v65, v3
    s_cmp_eq_u32 s3, 0
    v_cvt_pk_bf16_f32 v3, v3, v3
    ds_write_b16 v33, v3 offset:1024
    s_cbranch_scc0 L_nob1
    v_mul_f32 v68, s57, v68
    ds_write_b32 v8, v68
L_nob1:
    s_waitcnt lgkmcnt(0)
    s_barrier
    buffer_load_dwordx4 v[116:119], v53, s[20:23], 0 offen nt
    s_cmp_eq_u32 s28, 0
    s_cbranch_scc1 L_short0
    buffer_load_dwordx4 v[120:123], v54, s[20:23], 0 offen nt
L_short0:
    ds_read_b128 v[64:67], v15 offset:0
    ds_read_b128 v[80:83], v15 offset:4096
    ds_read_b128 v[68:71], v15 offset:1024
    ds_read_b128 v[84:87], v15 offset:5120
    ds_read_b128 v[72:75], v15 offset:2048
    ds_read_b128 v[88:91], v15 offset:6144
    ds_read_b128 v[76:79], v15 offset:3072
    ds_read_b128 v[92:95], v15 offset:7168
    ds_read_b128 v[48:51], v16
    ds_read_b128 v[52:55], v16 offset:64
    ds_read_b64 v[24:25], v17
    ds_read_b64 v[26:27], v17 offset:32
    s_lshl_b32 s39, s39, 16
    v_lshlrev_b32 v96, 16, v28
    v_and_b32 v97, 0xffff0000, v28
    v_lshlrev_b32 v98, 16, v29
    v_and_b32 v99, 0xffff0000, v29
    v_lshlrev_b32 v100, 16, v30
    v_and_b32 v101, 0xffff0000, v30
    v_lshlrev_b32 v102, 16, v31
    v_and_b32 v103, 0xffff0000, v31
    v_cmp_ne_u32_sdwa s[62:63], v6, s72 src0_sel:WORD_0 src1_sel:DWORD
    v_cmp_ne_u32_sdwa s[64:65], v6, s72 src0_sel:WORD_1 src1_sel:DWORD
    v_cmp_ne_u32_sdwa s[66:67], v7, s72 src0_sel:WORD_0 src1_sel:DWORD
    v_cmp_ne_u32_sdwa s[68:69], v7, s72 src0_sel:WORD_1 src1_sel:DWORD
    v_mov_b32 v20, s39
    v_mov_b32 v21, s39
    v_mov_b32 v22, s39
    v_mov_b32 v23, s39
    s_waitcnt lgkmcnt(10)
    v_fma_f32 v64, v80, v96, v64
    v_fma_f32 v65, v81, v97, v65
    v_fma_f32 v66, v82, v98, v66
    v_fma_f32 v67, v83, v99, v67
    ds_read_b128 v[80:83], v15 offset:8192
    s_waitcnt lgkmcnt(9)
    v_fma_f32 v68, v84, v100, v68
    v_fma_f32 v69, v85, v101, v69
    v_fma_f32 v70, v86, v102, v70
    v_fma_f32 v71, v87, v103, v71
    ds_read_b128 v[84:87], v15 offset:9216
    s_waitcnt lgkmcnt(8)
    v_fma_f32 v72, v88, v96, v72
    v_fma_f32 v73, v89, v97, v73
    v_fma_f32 v74, v90, v98, v74
    v_fma_f32 v75, v91, v99, v75
    ds_read_b128 v[88:91], v15 offset:10240
    s_waitcnt lgkmcnt(7)
    v_fma_f32 v76, v92, v100, v76
    v_fma_f32 v77, v93, v101, v77
    v_fma_f32 v78, v94, v102, v78
    v_fma_f32 v79, v95, v103, v79
    ds_read_b128 v[92:95], v15 offset:11264
    s_and_b64 s[62:63], s[62:63], s[40:41]
    s_and_b64 s[64:65], s[64:65], s[42:43]
    s_and_b64 s[66:67], s[66:67], s[44:45]
    s_and_b64 s[68:69], s[68:69], s[46:47]
    s_or_b64 s[62:63], s[62:63], s[64:65]
    s_or_b64 s[66:67], s[66:67], s[68:69]
    s_or_b64 s[70:71], s[62:63], s[66:67]
    s_cbranch_scc0 L_nomlist
    v_mov_b32 v100, 0
    v_mov_b32 v101, 0
    v_mov_b32 v102, 0
    v_mov_b32 v103, 0
    v_lshlrev_b32 v3, 4, v1
    v_add_u32 v3, s55, v3
    s_mov_b32 exec_lo, -1
    s_mov_b32 exec_hi, 0x00ffffff
    ds_write_b128 v3, v[100:103]
    s_mov_b64 exec, -1
    v_lshlrev_b32 v96, 16, v6
    v_and_b32 v97, 0xffff0000, v6
    v_lshlrev_b32 v98, 16, v7
    v_and_b32 v99, 0xffff0000, v7
    s_add_u32 s37, s55, 896
    s_lshl_b32 s37, s37, 2
    s_sub_u32 s37, s55, s37
    s_waitcnt lgkmcnt(0)
    v_lshl_add_u32 v100, v40, 2, s37
    v_lshl_add_u32 v101, v41, 2, s37
    v_lshl_add_u32 v102, v42, 2, s37
    v_lshl_add_u32 v103, v43, 2, s37
    s_mov_b64 exec, s[40:41]
    ds_write_b32 v100, v96
    s_mov_b64 exec, s[42:43]
    ds_write_b32 v101, v97
    s_mov_b64 exec, s[44:45]
    ds_write_b32 v102, v98
    s_mov_b64 exec, s[46:47]
    ds_write_b32 v103, v99
    s_mov_b64 exec, -1
    v_lshl_add_u32 v39, v2, 4, s55
L_nomlist:
    v_cvt_pk_bf16_f32 v40, v64, v65
    v_cvt_pk_bf16_f32 v41, v66, v67
    v_cvt_pk_bf16_f32 v42, v68, v69
    v_cvt_pk_bf16_f32 v43, v70, v71
    v_cvt_pk_bf16_f32 v44, v72, v73
    v_cvt_pk_bf16_f32 v45, v74, v75
    v_cvt_pk_bf16_f32 v46, v76, v77
    v_cvt_pk_bf16_f32 v47, v78, v79
    s_waitcnt lgkmcnt(0)
    v_mfma_f32_16x16x32_bf16 v[48:51], v[80:83], v[28:31], v[48:51]
    v_mfma_f32_16x16x32_bf16 v[52:55], v[88:91], v[28:31], v[52:55]
    v_mfma_f32_16x16x32_bf16 v[48:51], v[84:87], v[28:31], v[48:51]
    v_mfma_f32_16x16x32_bf16 v[52:55], v[92:95], v[28:31], v[52:55]
    s_cmp_eq_u32 s53, 0
    s_cbranch_scc1 L_epi
    s_cmp_eq_u64 s[70:71], 0
    s_cbranch_scc0 L_gen
    s_cmp_lg_u32 s28, 0
    s_cbranch_scc1 L_long
    ds_read_u8 v102, v34 offset:928
    s_mov_b32 s29, 0
    s_cmp_lt_u32 2, s53
    s_cselect_b64 s[30:31], -1, 1
    s_waitcnt vmcnt(1) lgkmcnt(0)
    v_lshl_or_b32 v102, v102, 6, v35
    s_mov_b64 exec, s[30:31]
    buffer_load_dwordx4 v[120:123], v102, s[20:23], 0 offen nt
    s_mov_b64 exec, -1
    ds_write_b128 v36, v[112:115]
    ds_read_b64_tr_b16 v[68:69], v37
    ds_read_b64_tr_b16 v[70:71], v38
    v_mfma_f32_16x16x32_bf16 v[76:79], v[40:43], v[112:115], v[48:51]
    v_mfma_f32_16x16x32_bf16 v[80:83], v[44:47], v[112:115], v[52:55]
L_loop_f:
    s_add_u32 s29, s29, 1
    s_add_u32 s37, s29, 2
    s_cmp_lt_u32 s37, s53
    s_cselect_b64 s[30:31], -1, 1
    ds_read_u8 v102, v34 offset:944
    s_nop 1
    v_exp_f32 v76, v76
    v_exp_f32 v77, v77
    v_exp_f32 v78, v78
    v_exp_f32 v79, v79
    v_cvt_pk_bf16_f32 v100, v104, v105
    v_cvt_pk_bf16_f32 v101, v106, v107
    v_exp_f32 v80, v80
    v_exp_f32 v81, v81
    v_exp_f32 v82, v82
    v_exp_f32 v83, v83
    v_mfma_f32_16x16x16_bf16 v[56:59], v[100:101], v[108:109], v[56:59]
    v_mfma_f32_16x16x16_bf16 v[60:63], v[100:101], v[110:111], v[60:63]
    v_add_f32 v76, 1.0, v76
    v_add_f32 v77, 1.0, v77
    v_add_f32 v78, 1.0, v78
    v_add_f32 v79, 1.0, v79
    v_add_f32 v80, 1.0, v80
    v_add_f32 v81, 1.0, v81
    v_add_f32 v82, 1.0, v82
    v_add_f32 v83, 1.0, v83
    v_rcp_f32 v76, v76
    v_rcp_f32 v77, v77
    v_rcp_f32 v78, v78
    v_rcp_f32 v79, v79
    v_rcp_f32 v80, v80
    v_rcp_f32 v81, v81
    v_rcp_f32 v82, v82
    v_rcp_f32 v83, v83
    v_cvt_pk_bf16_f32 v92, v76, v77
    v_cvt_pk_bf16_f32 v93, v78, v79
    v_cvt_pk_bf16_f32 v94, v80, v81
    v_cvt_pk_bf16_f32 v95, v82, v83
    s_cmp_ge_u32 s29, s53
    s_nop 0
    v_mfma_f32_16x16x32_bf16 v[104:107], v[92:95], v[24:27], v[20:23]
    s_cbranch_scc1 L_flush0_f
    s_waitcnt vmcnt(1) lgkmcnt(0)
    v_lshl_or_b32 v102, v102, 6, v35
    s_mov_b64 exec, s[30:31]
    buffer_load_dwordx4 v[124:127], v102, s[20:23], 0 offen nt
    s_mov_b64 exec, -1
    ds_write_b128 v36, v[116:119]
    ds_read_b64_tr_b16 v[108:109], v37
    ds_read_b64_tr_b16 v[110:111], v38
    v_mfma_f32_16x16x32_bf16 v[84:87], v[40:43], v[116:119], v[48:51]
    v_mfma_f32_16x16x32_bf16 v[88:91], v[44:47], v[116:119], v[52:55]
    s_add_u32 s29, s29, 1
    s_add_u32 s37, s29, 2
    s_cmp_lt_u32 s37, s53
    s_cselect_b64 s[30:31], -1, 1
    ds_read_u8 v102, v34 offset:960
    s_nop 1
    v_exp_f32 v84, v84
    v_exp_f32 v85, v85
    v_exp_f32 v86, v86
    v_exp_f32 v87, v87
    v_cvt_pk_bf16_f32 v100, v104, v105
    v_cvt_pk_bf16_f32 v101, v106, v107
    v_exp_f32 v88, v88
    v_exp_f32 v89, v89
    v_exp_f32 v90, v90
    v_exp_f32 v91, v91
    v_mfma_f32_16x16x16_bf16 v[56:59], v[100:101], v[68:69], v[56:59]
    v_mfma_f32_16x16x16_bf16 v[60:63], v[100:101], v[70:71], v[60:63]
    v_add_f32 v84, 1.0, v84
    v_add_f32 v85, 1.0, v85
    v_add_f32 v86, 1.0, v86
    v_add_f32 v87, 1.0, v87
    v_add_f32 v88, 1.0, v88
    v_add_f32 v89, 1.0, v89
    v_add_f32 v90, 1.0, v90
    v_add_f32 v91, 1.0, v91
    v_rcp_f32 v84, v84
    v_rcp_f32 v85, v85
    v_rcp_f32 v86, v86
    v_rcp_f32 v87, v87
    v_rcp_f32 v88, v88
    v_rcp_f32 v89, v89
    v_rcp_f32 v90, v90
    v_rcp_f32 v91, v91
    v_cvt_pk_bf16_f32 v92, v84, v85
    v_cvt_pk_bf16_f32 v93, v86, v87
    v_cvt_pk_bf16_f32 v94, v88, v89
    v_cvt_pk_bf16_f32 v95, v90, v91
    s_cmp_ge_u32 s29, s53
    s_nop 0
    v_mfma_f32_16x16x32_bf16 v[104:107], v[92:95], v[24:27], v[20:23]
    s_cbranch_scc1 L_flush1_f
    s_waitcnt vmcnt(1) lgkmcnt(0)
    v_lshl_or_b32 v102, v102, 6, v35
    s_mov_b64 exec, s[30:31]
    buffer_load_dwordx4 v[112:115], v102, s[20:23], 0 offen nt
    s_mov_b64 exec, -1
    ds_write_b128 v36, v[120:123]
    ds_read_b64_tr_b16 v[68:69], v37
    ds_read_b64_tr_b16 v[70:71], v38
    v_mfma_f32_16x16x32_bf16 v[76:79], v[40:43], v[120:123], v[48:51]
    v_mfma_f32_16x16x32_bf16 v[80:83], v[44:47], v[120:123], v[52:55]
    s_add_u32 s29, s29, 1
    s_add_u32 s37, s29, 2
    s_cmp_lt_u32 s37, s53
    s_cselect_b64 s[30:31], -1, 1
    ds_read_u8 v102, v34 offset:976
    s_nop 1
    v_exp_f32 v76, v76
    v_exp_f32 v77, v77
    v_exp_f32 v78, v78
    v_exp_f32 v79, v79
    v_cvt_pk_bf16_f32 v100, v104, v105
    v_cvt_pk_bf16_f32 v101, v106, v107
    v_exp_f32 v80, v80
    v_exp_f32 v81, v81
    v_exp_f32 v82, v82
    v_exp_f32 v83, v83
    v_mfma_f32_16x16x16_bf16 v[56:59], v[100:101], v[108:109], v[56:59]
    v_mfma_f32_16x16x16_bf16 v[60:63], v[100:101], v[110:111], v[60:63]
    v_add_f32 v76, 1.0, v76
    v_add_f32 v77, 1.0, v77
    v_add_f32 v78, 1.0, v78
    v_add_f32 v79, 1.0, v79
    v_add_f32 v80, 1.0, v80
    v_add_f32 v81, 1.0, v81
    v_add_f32 v82, 1.0, v82
    v_add_f32 v83, 1.0, v83
    v_rcp_f32 v76, v76
    v_rcp_f32 v77, v77
    v_rcp_f32 v78, v78
    v_rcp_f32 v79, v79
    v_rcp_f32 v80, v80
    v_rcp_f32 v81, v81
    v_rcp_f32 v82, v82
    v_rcp_f32 v83, v83
    v_cvt_pk_bf16_f32 v92, v76, v77
    v_cvt_pk_bf16_f32 v93, v78, v79
    v_cvt_pk_bf16_f32 v94, v80, v81
    v_cvt_pk_bf16_f32 v95, v82, v83
    s_cmp_ge_u32 s29, s53
    s_nop 0
    v_mfma_f32_16x16x32_bf16 v[104:107], v[92:95], v[24:27], v[20:23]
    s_cbranch_scc1 L_flush0_f
    s_waitcnt vmcnt(1) lgkmcnt(0)
    v_lshl_or_b32 v102, v102, 6, v35
    s_mov_b64 exec, s[30:31]
    buffer_load_dwordx4 v[116:119], v102, s[20:23], 0 offen nt
    s_mov_b64 exec, -1
    ds_write_b128 v36, v[124:127]
    ds_read_b64_tr_b16 v[108:109], v37
    ds_read_b64_tr_b16 v[110:111], v38
    v_mfma_f32_16x16x32_bf16 v[84:87], v[40:43], v[124:127], v[48:51]
    v_mfma_f32_16x16x32_bf16 v[88:91], v[44:47], v[124:127], v[52:55]
    s_add_u32 s29, s29, 1
    s_add_u32 s37, s29, 2
    s_cmp_lt_u32 s37, s53
    s_cselect_b64 s[30:31], -1, 1
    ds_read_u8 v102, v34 offset:992
    s_nop 1
    v_exp_f32 v84, v84
    v_exp_f32 v85, v85
    v_exp_f32 v86, v86
    v_exp_f32 v87, v87
    v_cvt_pk_bf16_f32 v100, v104, v105
    v_cvt_pk_bf16_f32 v101, v106, v107
    v_exp_f32 v88, v88
    v_exp_f32 v89, v89
    v_exp_f32 v90, v90
    v_exp_f32 v91, v91
    v_mfma_f32_16x16x16_bf16 v[56:59], v[100:101], v[68:69], v[56:59]
    v_mfma_f32_16x16x16_bf16 v[60:63], v[100:101], v[70:71], v[60:63]
    v_add_f32 v84, 1.0, v84
    v_add_f32 v85, 1.0, v85
    v_add_f32 v86, 1.0, v86
    v_add_f32 v87, 1.0, v87
    v_add_f32 v88, 1.0, v88
    v_add_f32 v89, 1.0, v89
    v_add_f32 v90, 1.0, v90
    v_add_f32 v91, 1.0, v91
    v_rcp_f32 v84, v84
    v_rcp_f32 v85, v85
    v_rcp_f32 v86, v86
    v_rcp_f32 v87, v87
    v_rcp_f32 v88, v88
    v_rcp_f32 v89, v89
    v_rcp_f32 v90, v90
    v_rcp_f32 v91, v91
    v_cvt_pk_bf16_f32 v92, v84, v85
    v_cvt_pk_bf16_f32 v93, v86, v87
    v_cvt_pk_bf16_f32 v94, v88, v89
    v_cvt_pk_bf16_f32 v95, v90, v91
    s_cmp_ge_u32 s29, s53
    s_nop 0
    v_mfma_f32_16x16x32_bf16 v[104:107], v[92:95], v[24:27], v[20:23]
    s_cbranch_scc1 L_flush1_f
    s_waitcnt vmcnt(1) lgkmcnt(0)
    v_lshl_or_b32 v102, v102, 6, v35
    s_mov_b64 exec, s[30:31]
    buffer_load_dwordx4 v[120:123], v102, s[20:23], 0 offen nt
    s_mov_b64 exec, -1
    v_add_u32 v34, 64, v34
    ds_write_b128 v36, v[112:115]
    ds_read_b64_tr_b16 v[68:69], v37
    ds_read_b64_tr_b16 v[70:71], v38
    v_mfma_f32_16x16x32_bf16 v[76:79], v[40:43], v[112:115], v[48:51]
    v_mfma_f32_16x16x32_bf16 v[80:83], v[44:47], v[112:115], v[52:55]
    s_branch L_loop_f
L_flush0_f:
    s_waitcnt lgkmcnt(0)
    s_nop 5
    v_cvt_pk_bf16_f32 v100, v104, v105
    v_cvt_pk_bf16_f32 v101, v106, v107
    s_nop 1
    v_mfma_f32_16x16x16_bf16 v[56:59], v[100:101], v[68:69], v[56:59]
    v_mfma_f32_16x16x16_bf16 v[60:63], v[100:101], v[70:71], v[60:63]
    s_branch L_epi
L_flush1_f:
    s_waitcnt lgkmcnt(0)
    s_nop 5
    v_cvt_pk_bf16_f32 v100, v104, v105
    v_cvt_pk_bf16_f32 v101, v106, v107
    s_nop 1
    v_mfma_f32_16x16x16_bf16 v[56:59], v[100:101], v[108:109], v[56:59]
    v_mfma_f32_16x16x16_bf16 v[60:63], v[100:101], v[110:111], v[60:63]
L_epi:
    s_nop 7
    v_cndmask_b32_e64 v3, v60, v56, s[58:59]
    v_cvt_pk_bf16_f32 v3, v3, v3
    buffer_store_short v3, v5, s[32:35], 0 offen
    s_endpgm
L_long:
    ds_read_u8 v102, v34 offset:944
    s_mov_b32 s29, 0
    s_cmp_lt_u32 3, s53
    s_cselect_b64 s[30:31], -1, 1
    s_waitcnt vmcnt(2) lgkmcnt(0)
    v_lshl_or_b32 v102, v102, 6, v35
    s_mov_b64 exec, s[30:31]
    buffer_load_dwordx4 v[124:127], v102, s[20:23], 0 offen nt
    s_mov_b64 exec, -1
    ds_write_b128 v36, v[112:115]
    ds_read_b64_tr_b16 v[68:69], v37
    ds_read_b64_tr_b16 v[70:71], v38
    v_mfma_f32_16x16x32_bf16 v[76:79], v[40:43], v[112:115], v[48:51]
    v_mfma_f32_16x16x32_bf16 v[80:83], v[44:47], v[112:115], v[52:55]
L_loop_l:
    s_add_u32 s29, s29, 1
    s_add_u32 s37, s29, 3
    s_cmp_lt_u32 s37, s53
    s_cselect_b64 s[30:31], -1, 1
    ds_read_u8 v102, v34 offset:960
    s_nop 1
    v_exp_f32 v76, v76
    v_exp_f32 v77, v77
    v_exp_f32 v78, v78
    v_exp_f32 v79, v79
    v_cvt_pk_bf16_f32 v100, v104, v105
    v_cvt_pk_bf16_f32 v101, v106, v107
    v_exp_f32 v80, v80
    v_exp_f32 v81, v81
    v_exp_f32 v82, v82
    v_exp_f32 v83, v83
    v_mfma_f32_16x16x16_bf16 v[56:59], v[100:101], v[108:109], v[56:59]
    v_mfma_f32_16x16x16_bf16 v[60:63], v[100:101], v[110:111], v[60:63]
    v_add_f32 v76, 1.0, v76
    v_add_f32 v77, 1.0, v77
    v_add_f32 v78, 1.0, v78
    v_add_f32 v79, 1.0, v79
    v_add_f32 v80, 1.0, v80
    v_add_f32 v81, 1.0, v81
    v_add_f32 v82, 1.0, v82
    v_add_f32 v83, 1.0, v83
    v_rcp_f32 v76, v76
    v_rcp_f32 v77, v77
    v_rcp_f32 v78, v78
    v_rcp_f32 v79, v79
    v_rcp_f32 v80, v80
    v_rcp_f32 v81, v81
    v_rcp_f32 v82, v82
    v_rcp_f32 v83, v83
    v_cvt_pk_bf16_f32 v92, v76, v77
    v_cvt_pk_bf16_f32 v93, v78, v79
    v_cvt_pk_bf16_f32 v94, v80, v81
    v_cvt_pk_bf16_f32 v95, v82, v83
    s_cmp_ge_u32 s29, s53
    s_nop 0
    v_mfma_f32_16x16x32_bf16 v[104:107], v[92:95], v[24:27], v[20:23]
    s_cbranch_scc1 L_flush0_l
    s_waitcnt vmcnt(2) lgkmcnt(0)
    v_lshl_or_b32 v102, v102, 6, v35
    s_mov_b64 exec, s[30:31]
    buffer_load_dwordx4 v[112:115], v102, s[20:23], 0 offen nt
    s_mov_b64 exec, -1
    ds_write_b128 v36, v[116:119]
    ds_read_b64_tr_b16 v[108:109], v37
    ds_read_b64_tr_b16 v[110:111], v38
    v_mfma_f32_16x16x32_bf16 v[84:87], v[40:43], v[116:119], v[48:51]
    v_mfma_f32_16x16x32_bf16 v[88:91], v[44:47], v[116:119], v[52:55]
    s_add_u32 s29, s29, 1
    s_add_u32 s37, s29, 3
    s_cmp_lt_u32 s37, s53
    s_cselect_b64 s[30:31], -1, 1
    ds_read_u8 v102, v34 offset:976
    s_nop 1
    v_exp_f32 v84, v84
    v_exp_f32 v85, v85
    v_exp_f32 v86, v86
    v_exp_f32 v87, v87
    v_cvt_pk_bf16_f32 v100, v104, v105
    v_cvt_pk_bf16_f32 v101, v106, v107
    v_exp_f32 v88, v88
    v_exp_f32 v89, v89
    v_exp_f32 v90, v90
    v_exp_f32 v91, v91
    v_mfma_f32_16x16x16_bf16 v[56:59], v[100:101], v[68:69], v[56:59]
    v_mfma_f32_16x16x16_bf16 v[60:63], v[100:101], v[70:71], v[60:63]
    v_add_f32 v84, 1.0, v84
    v_add_f32 v85, 1.0, v85
    v_add_f32 v86, 1.0, v86
    v_add_f32 v87, 1.0, v87
    v_add_f32 v88, 1.0, v88
    v_add_f32 v89, 1.0, v89
    v_add_f32 v90, 1.0, v90
    v_add_f32 v91, 1.0, v91
    v_rcp_f32 v84, v84
    v_rcp_f32 v85, v85
    v_rcp_f32 v86, v86
    v_rcp_f32 v87, v87
    v_rcp_f32 v88, v88
    v_rcp_f32 v89, v89
    v_rcp_f32 v90, v90
    v_rcp_f32 v91, v91
    v_cvt_pk_bf16_f32 v92, v84, v85
    v_cvt_pk_bf16_f32 v93, v86, v87
    v_cvt_pk_bf16_f32 v94, v88, v89
    v_cvt_pk_bf16_f32 v95, v90, v91
    s_cmp_ge_u32 s29, s53
    s_nop 0
    v_mfma_f32_16x16x32_bf16 v[104:107], v[92:95], v[24:27], v[20:23]
    s_cbranch_scc1 L_flush1_l
    s_waitcnt vmcnt(2) lgkmcnt(0)
    v_lshl_or_b32 v102, v102, 6, v35
    s_mov_b64 exec, s[30:31]
    buffer_load_dwordx4 v[116:119], v102, s[20:23], 0 offen nt
    s_mov_b64 exec, -1
    ds_write_b128 v36, v[120:123]
    ds_read_b64_tr_b16 v[68:69], v37
    ds_read_b64_tr_b16 v[70:71], v38
    v_mfma_f32_16x16x32_bf16 v[76:79], v[40:43], v[120:123], v[48:51]
    v_mfma_f32_16x16x32_bf16 v[80:83], v[44:47], v[120:123], v[52:55]
    s_add_u32 s29, s29, 1
    s_add_u32 s37, s29, 3
    s_cmp_lt_u32 s37, s53
    s_cselect_b64 s[30:31], -1, 1
    ds_read_u8 v102, v34 offset:992
    s_nop 1
    v_exp_f32 v76, v76
    v_exp_f32 v77, v77
    v_exp_f32 v78, v78
    v_exp_f32 v79, v79
    v_cvt_pk_bf16_f32 v100, v104, v105
    v_cvt_pk_bf16_f32 v101, v106, v107
    v_exp_f32 v80, v80
    v_exp_f32 v81, v81
    v_exp_f32 v82, v82
    v_exp_f32 v83, v83
    v_mfma_f32_16x16x16_bf16 v[56:59], v[100:101], v[108:109], v[56:59]
    v_mfma_f32_16x16x16_bf16 v[60:63], v[100:101], v[110:111], v[60:63]
    v_add_f32 v76, 1.0, v76
    v_add_f32 v77, 1.0, v77
    v_add_f32 v78, 1.0, v78
    v_add_f32 v79, 1.0, v79
    v_add_f32 v80, 1.0, v80
    v_add_f32 v81, 1.0, v81
    v_add_f32 v82, 1.0, v82
    v_add_f32 v83, 1.0, v83
    v_rcp_f32 v76, v76
    v_rcp_f32 v77, v77
    v_rcp_f32 v78, v78
    v_rcp_f32 v79, v79
    v_rcp_f32 v80, v80
    v_rcp_f32 v81, v81
    v_rcp_f32 v82, v82
    v_rcp_f32 v83, v83
    v_cvt_pk_bf16_f32 v92, v76, v77
    v_cvt_pk_bf16_f32 v93, v78, v79
    v_cvt_pk_bf16_f32 v94, v80, v81
    v_cvt_pk_bf16_f32 v95, v82, v83
    s_cmp_ge_u32 s29, s53
    s_nop 0
    v_mfma_f32_16x16x32_bf16 v[104:107], v[92:95], v[24:27], v[20:23]
    s_cbranch_scc1 L_flush0_l
    s_waitcnt vmcnt(2) lgkmcnt(0)
    v_lshl_or_b32 v102, v102, 6, v35
    s_mov_b64 exec, s[30:31]
    buffer_load_dwordx4 v[120:123], v102, s[20:23], 0 offen nt
    s_mov_b64 exec, -1
    ds_write_b128 v36, v[124:127]
    ds_read_b64_tr_b16 v[108:109], v37
    ds_read_b64_tr_b16 v[110:111], v38
    v_mfma_f32_16x16x32_bf16 v[84:87], v[40:43], v[124:127], v[48:51]
    v_mfma_f32_16x16x32_bf16 v[88:91], v[44:47], v[124:127], v[52:55]
    s_add_u32 s29, s29, 1
    s_add_u32 s37, s29, 3
    s_cmp_lt_u32 s37, s53
    s_cselect_b64 s[30:31], -1, 1
    ds_read_u8 v102, v34 offset:1008
    s_nop 1
    v_exp_f32 v84, v84
    v_exp_f32 v85, v85
    v_exp_f32 v86, v86
    v_exp_f32 v87, v87
    v_cvt_pk_bf16_f32 v100, v104, v105
    v_cvt_pk_bf16_f32 v101, v106, v107
    v_exp_f32 v88, v88
    v_exp_f32 v89, v89
    v_exp_f32 v90, v90
    v_exp_f32 v91, v91
    v_mfma_f32_16x16x16_bf16 v[56:59], v[100:101], v[68:69], v[56:59]
    v_mfma_f32_16x16x16_bf16 v[60:63], v[100:101], v[70:71], v[60:63]
    v_add_f32 v84, 1.0, v84
    v_add_f32 v85, 1.0, v85
    v_add_f32 v86, 1.0, v86
    v_add_f32 v87, 1.0, v87
    v_add_f32 v88, 1.0, v88
    v_add_f32 v89, 1.0, v89
    v_add_f32 v90, 1.0, v90
    v_add_f32 v91, 1.0, v91
    v_rcp_f32 v84, v84
    v_rcp_f32 v85, v85
    v_rcp_f32 v86, v86
    v_rcp_f32 v87, v87
    v_rcp_f32 v88, v88
    v_rcp_f32 v89, v89
    v_rcp_f32 v90, v90
    v_rcp_f32 v91, v91
    v_cvt_pk_bf16_f32 v92, v84, v85
    v_cvt_pk_bf16_f32 v93, v86, v87
    v_cvt_pk_bf16_f32 v94, v88, v89
    v_cvt_pk_bf16_f32 v95, v90, v91
    s_cmp_ge_u32 s29, s53
    s_nop 0
    v_mfma_f32_16x16x32_bf16 v[104:107], v[92:95], v[24:27], v[20:23]
    s_cbranch_scc1 L_flush1_l
    s_waitcnt vmcnt(2) lgkmcnt(0)
    v_lshl_or_b32 v102, v102, 6, v35
    s_mov_b64 exec, s[30:31]
    buffer_load_dwordx4 v[124:127], v102, s[20:23], 0 offen nt
    s_mov_b64 exec, -1
    v_add_u32 v34, 64, v34
    ds_write_b128 v36, v[112:115]
    ds_read_b64_tr_b16 v[68:69], v37
    ds_read_b64_tr_b16 v[70:71], v38
    v_mfma_f32_16x16x32_bf16 v[76:79], v[40:43], v[112:115], v[48:51]
    v_mfma_f32_16x16x32_bf16 v[80:83], v[44:47], v[112:115], v[52:55]
    s_branch L_loop_l
L_flush0_l:
    s_waitcnt lgkmcnt(0)
    s_nop 5
    v_cvt_pk_bf16_f32 v100, v104, v105
    v_cvt_pk_bf16_f32 v101, v106, v107
    s_nop 1
    v_mfma_f32_16x16x16_bf16 v[56:59], v[100:101], v[68:69], v[56:59]
    v_mfma_f32_16x16x16_bf16 v[60:63], v[100:101], v[70:71], v[60:63]
    s_branch L_epi
L_flush1_l:
    s_waitcnt lgkmcnt(0)
    s_nop 5
    v_cvt_pk_bf16_f32 v100, v104, v105
    v_cvt_pk_bf16_f32 v101, v106, v107
    s_nop 1
    v_mfma_f32_16x16x16_bf16 v[56:59], v[100:101], v[108:109], v[56:59]
    v_mfma_f32_16x16x16_bf16 v[60:63], v[100:101], v[110:111], v[60:63]
    s_branch L_epi
L_gen:
    s_cmp_lg_u32 s28, 0
    s_cbranch_scc1 L_genlong
    ds_read_u8 v102, v34 offset:928
    s_mov_b32 s29, 0
    s_cmp_lt_u32 2, s53
    s_cselect_b64 s[30:31], -1, 1
    v_mov_b32 v10, 0
    v_mov_b32 v11, 0
    v_mov_b32 v12, 0
    v_mov_b32 v13, 0
    s_waitcnt vmcnt(1) lgkmcnt(0)
    v_lshl_or_b32 v102, v102, 6, v35
    s_mov_b64 exec, s[30:31]
    buffer_load_dwordx4 v[120:123], v102, s[20:23], 0 offen nt
    s_mov_b64 exec, -1
    ds_write_b128 v36, v[112:115]
    ds_read_b64_tr_b16 v[68:69], v37
    ds_read_b64_tr_b16 v[70:71], v38
    ds_read_b128 v[6:9], v39 offset:0
    v_mfma_f32_16x16x32_bf16 v[76:79], v[40:43], v[112:115], v[48:51]
    v_mfma_f32_16x16x32_bf16 v[80:83], v[44:47], v[112:115], v[52:55]
L_loop_m:
    s_add_u32 s29, s29, 1
    s_add_u32 s37, s29, 2
    s_cmp_lt_u32 s37, s53
    s_cselect_b64 s[30:31], -1, 1
    ds_read_u8 v102, v34 offset:944
    s_nop 1
    v_exp_f32 v76, v76
    v_exp_f32 v77, v77
    v_exp_f32 v78, v78
    v_exp_f32 v79, v79
    v_mul_f32 v104, v104, v10
    v_mul_f32 v105, v105, v11
    v_mul_f32 v106, v106, v12
    v_mul_f32 v107, v107, v13
    v_cvt_pk_bf16_f32 v100, v104, v105
    v_cvt_pk_bf16_f32 v101, v106, v107
    v_exp_f32 v80, v80
    v_exp_f32 v81, v81
    v_exp_f32 v82, v82
    v_exp_f32 v83, v83
    v_mfma_f32_16x16x16_bf16 v[56:59], v[100:101], v[108:109], v[56:59]
    v_mfma_f32_16x16x16_bf16 v[60:63], v[100:101], v[110:111], v[60:63]
    v_add_f32 v76, 1.0, v76
    v_add_f32 v77, 1.0, v77
    v_add_f32 v78, 1.0, v78
    v_add_f32 v79, 1.0, v79
    v_add_f32 v80, 1.0, v80
    v_add_f32 v81, 1.0, v81
    v_add_f32 v82, 1.0, v82
    v_add_f32 v83, 1.0, v83
    v_rcp_f32 v76, v76
    v_rcp_f32 v77, v77
    v_rcp_f32 v78, v78
    v_rcp_f32 v79, v79
    v_rcp_f32 v80, v80
    v_rcp_f32 v81, v81
    v_rcp_f32 v82, v82
    v_rcp_f32 v83, v83
    v_cvt_pk_bf16_f32 v92, v76, v77
    v_cvt_pk_bf16_f32 v93, v78, v79
    v_cvt_pk_bf16_f32 v94, v80, v81
    v_cvt_pk_bf16_f32 v95, v82, v83
    s_cmp_ge_u32 s29, s53
    s_nop 0
    v_mfma_f32_16x16x32_bf16 v[104:107], v[92:95], v[24:27], v[20:23]
    s_cbranch_scc1 L_flush0_m
    s_waitcnt vmcnt(1) lgkmcnt(0)
    v_lshl_or_b32 v102, v102, 6, v35
    s_mov_b64 exec, s[30:31]
    buffer_load_dwordx4 v[124:127], v102, s[20:23], 0 offen nt
    s_mov_b64 exec, -1
    ds_write_b128 v36, v[116:119]
    ds_read_b64_tr_b16 v[108:109], v37
    ds_read_b64_tr_b16 v[110:111], v38
    ds_read_b128 v[10:13], v39 offset:64
    v_mfma_f32_16x16x32_bf16 v[84:87], v[40:43], v[116:119], v[48:51]
    v_mfma_f32_16x16x32_bf16 v[88:91], v[44:47], v[116:119], v[52:55]
    s_add_u32 s29, s29, 1
    s_add_u32 s37, s29, 2
    s_cmp_lt_u32 s37, s53
    s_cselect_b64 s[30:31], -1, 1
    ds_read_u8 v102, v34 offset:960
    s_nop 1
    v_exp_f32 v84, v84
    v_exp_f32 v85, v85
    v_exp_f32 v86, v86
    v_exp_f32 v87, v87
    v_mul_f32 v104, v104, v6
    v_mul_f32 v105, v105, v7
    v_mul_f32 v106, v106, v8
    v_mul_f32 v107, v107, v9
    v_cvt_pk_bf16_f32 v100, v104, v105
    v_cvt_pk_bf16_f32 v101, v106, v107
    v_exp_f32 v88, v88
    v_exp_f32 v89, v89
    v_exp_f32 v90, v90
    v_exp_f32 v91, v91
    v_mfma_f32_16x16x16_bf16 v[56:59], v[100:101], v[68:69], v[56:59]
    v_mfma_f32_16x16x16_bf16 v[60:63], v[100:101], v[70:71], v[60:63]
    v_add_f32 v84, 1.0, v84
    v_add_f32 v85, 1.0, v85
    v_add_f32 v86, 1.0, v86
    v_add_f32 v87, 1.0, v87
    v_add_f32 v88, 1.0, v88
    v_add_f32 v89, 1.0, v89
    v_add_f32 v90, 1.0, v90
    v_add_f32 v91, 1.0, v91
    v_rcp_f32 v84, v84
    v_rcp_f32 v85, v85
    v_rcp_f32 v86, v86
    v_rcp_f32 v87, v87
    v_rcp_f32 v88, v88
    v_rcp_f32 v89, v89
    v_rcp_f32 v90, v90
    v_rcp_f32 v91, v91
    v_cvt_pk_bf16_f32 v92, v84, v85
    v_cvt_pk_bf16_f32 v93, v86, v87
    v_cvt_pk_bf16_f32 v94, v88, v89
    v_cvt_pk_bf16_f32 v95, v90, v91
    s_cmp_ge_u32 s29, s53
    s_nop 0
    v_mfma_f32_16x16x32_bf16 v[104:107], v[92:95], v[24:27], v[20:23]
    s_cbranch_scc1 L_flush1_m
    s_waitcnt vmcnt(1) lgkmcnt(0)
    v_lshl_or_b32 v102, v102, 6, v35
    s_mov_b64 exec, s[30:31]
    buffer_load_dwordx4 v[112:115], v102, s[20:23], 0 offen nt
    s_mov_b64 exec, -1
    ds_write_b128 v36, v[120:123]
    ds_read_b64_tr_b16 v[68:69], v37
    ds_read_b64_tr_b16 v[70:71], v38
    ds_read_b128 v[6:9], v39 offset:128
    v_mfma_f32_16x16x32_bf16 v[76:79], v[40:43], v[120:123], v[48:51]
    v_mfma_f32_16x16x32_bf16 v[80:83], v[44:47], v[120:123], v[52:55]
    s_add_u32 s29, s29, 1
    s_add_u32 s37, s29, 2
    s_cmp_lt_u32 s37, s53
    s_cselect_b64 s[30:31], -1, 1
    ds_read_u8 v102, v34 offset:976
    s_nop 1
    v_exp_f32 v76, v76
    v_exp_f32 v77, v77
    v_exp_f32 v78, v78
    v_exp_f32 v79, v79
    v_mul_f32 v104, v104, v10
    v_mul_f32 v105, v105, v11
    v_mul_f32 v106, v106, v12
    v_mul_f32 v107, v107, v13
    v_cvt_pk_bf16_f32 v100, v104, v105
    v_cvt_pk_bf16_f32 v101, v106, v107
    v_exp_f32 v80, v80
    v_exp_f32 v81, v81
    v_exp_f32 v82, v82
    v_exp_f32 v83, v83
    v_mfma_f32_16x16x16_bf16 v[56:59], v[100:101], v[108:109], v[56:59]
    v_mfma_f32_16x16x16_bf16 v[60:63], v[100:101], v[110:111], v[60:63]
    v_add_f32 v76, 1.0, v76
    v_add_f32 v77, 1.0, v77
    v_add_f32 v78, 1.0, v78
    v_add_f32 v79, 1.0, v79
    v_add_f32 v80, 1.0, v80
    v_add_f32 v81, 1.0, v81
    v_add_f32 v82, 1.0, v82
    v_add_f32 v83, 1.0, v83
    v_rcp_f32 v76, v76
    v_rcp_f32 v77, v77
    v_rcp_f32 v78, v78
    v_rcp_f32 v79, v79
    v_rcp_f32 v80, v80
    v_rcp_f32 v81, v81
    v_rcp_f32 v82, v82
    v_rcp_f32 v83, v83
    v_cvt_pk_bf16_f32 v92, v76, v77
    v_cvt_pk_bf16_f32 v93, v78, v79
    v_cvt_pk_bf16_f32 v94, v80, v81
    v_cvt_pk_bf16_f32 v95, v82, v83
    s_cmp_ge_u32 s29, s53
    s_nop 0
    v_mfma_f32_16x16x32_bf16 v[104:107], v[92:95], v[24:27], v[20:23]
    s_cbranch_scc1 L_flush0_m
    s_waitcnt vmcnt(1) lgkmcnt(0)
    v_lshl_or_b32 v102, v102, 6, v35
    s_mov_b64 exec, s[30:31]
    buffer_load_dwordx4 v[116:119], v102, s[20:23], 0 offen nt
    s_mov_b64 exec, -1
    ds_write_b128 v36, v[124:127]
    ds_read_b64_tr_b16 v[108:109], v37
    ds_read_b64_tr_b16 v[110:111], v38
    ds_read_b128 v[10:13], v39 offset:192
    v_mfma_f32_16x16x32_bf16 v[84:87], v[40:43], v[124:127], v[48:51]
    v_mfma_f32_16x16x32_bf16 v[88:91], v[44:47], v[124:127], v[52:55]
    s_add_u32 s29, s29, 1
    s_add_u32 s37, s29, 2
    s_cmp_lt_u32 s37, s53
    s_cselect_b64 s[30:31], -1, 1
    ds_read_u8 v102, v34 offset:992
    s_nop 1
    v_exp_f32 v84, v84
    v_exp_f32 v85, v85
    v_exp_f32 v86, v86
    v_exp_f32 v87, v87
    v_mul_f32 v104, v104, v6
    v_mul_f32 v105, v105, v7
    v_mul_f32 v106, v106, v8
    v_mul_f32 v107, v107, v9
    v_cvt_pk_bf16_f32 v100, v104, v105
    v_cvt_pk_bf16_f32 v101, v106, v107
    v_exp_f32 v88, v88
    v_exp_f32 v89, v89
    v_exp_f32 v90, v90
    v_exp_f32 v91, v91
    v_mfma_f32_16x16x16_bf16 v[56:59], v[100:101], v[68:69], v[56:59]
    v_mfma_f32_16x16x16_bf16 v[60:63], v[100:101], v[70:71], v[60:63]
    v_add_f32 v84, 1.0, v84
    v_add_f32 v85, 1.0, v85
    v_add_f32 v86, 1.0, v86
    v_add_f32 v87, 1.0, v87
    v_add_f32 v88, 1.0, v88
    v_add_f32 v89, 1.0, v89
    v_add_f32 v90, 1.0, v90
    v_add_f32 v91, 1.0, v91
    v_rcp_f32 v84, v84
    v_rcp_f32 v85, v85
    v_rcp_f32 v86, v86
    v_rcp_f32 v87, v87
    v_rcp_f32 v88, v88
    v_rcp_f32 v89, v89
    v_rcp_f32 v90, v90
    v_rcp_f32 v91, v91
    v_cvt_pk_bf16_f32 v92, v84, v85
    v_cvt_pk_bf16_f32 v93, v86, v87
    v_cvt_pk_bf16_f32 v94, v88, v89
    v_cvt_pk_bf16_f32 v95, v90, v91
    v_add_u32 v39, 256, v39
    s_cmp_ge_u32 s29, s53
    v_mfma_f32_16x16x32_bf16 v[104:107], v[92:95], v[24:27], v[20:23]
    s_cbranch_scc1 L_flush1_m
    s_waitcnt vmcnt(1) lgkmcnt(0)
    v_lshl_or_b32 v102, v102, 6, v35
    s_mov_b64 exec, s[30:31]
    buffer_load_dwordx4 v[120:123], v102, s[20:23], 0 offen nt
    s_mov_b64 exec, -1
    v_add_u32 v34, 64, v34
    ds_write_b128 v36, v[112:115]
    ds_read_b64_tr_b16 v[68:69], v37
    ds_read_b64_tr_b16 v[70:71], v38
    ds_read_b128 v[6:9], v39 offset:0
    v_mfma_f32_16x16x32_bf16 v[76:79], v[40:43], v[112:115], v[48:51]
    v_mfma_f32_16x16x32_bf16 v[80:83], v[44:47], v[112:115], v[52:55]
    s_branch L_loop_m
L_flush0_m:
    s_waitcnt lgkmcnt(0)
    s_nop 5
    v_mul_f32 v104, v104, v6
    v_mul_f32 v105, v105, v7
    v_mul_f32 v106, v106, v8
    v_mul_f32 v107, v107, v9
    v_cvt_pk_bf16_f32 v100, v104, v105
    v_cvt_pk_bf16_f32 v101, v106, v107
    s_nop 1
    v_mfma_f32_16x16x16_bf16 v[56:59], v[100:101], v[68:69], v[56:59]
    v_mfma_f32_16x16x16_bf16 v[60:63], v[100:101], v[70:71], v[60:63]
    s_branch L_epi
L_flush1_m:
    s_waitcnt lgkmcnt(0)
    s_nop 5
    v_mul_f32 v104, v104, v10
    v_mul_f32 v105, v105, v11
    v_mul_f32 v106, v106, v12
    v_mul_f32 v107, v107, v13
    v_cvt_pk_bf16_f32 v100, v104, v105
    v_cvt_pk_bf16_f32 v101, v106, v107
    s_nop 1
    v_mfma_f32_16x16x16_bf16 v[56:59], v[100:101], v[108:109], v[56:59]
    v_mfma_f32_16x16x16_bf16 v[60:63], v[100:101], v[110:111], v[60:63]
    s_branch L_epi
L_genlong:
    ds_read_u8 v102, v34 offset:944
    s_mov_b32 s29, 0
    s_cmp_lt_u32 3, s53
    s_cselect_b64 s[30:31], -1, 1
    v_mov_b32 v10, 0
    v_mov_b32 v11, 0
    v_mov_b32 v12, 0
    v_mov_b32 v13, 0
    s_waitcnt vmcnt(2) lgkmcnt(0)
    v_lshl_or_b32 v102, v102, 6, v35
    s_mov_b64 exec, s[30:31]
    buffer_load_dwordx4 v[124:127], v102, s[20:23], 0 offen nt
    s_mov_b64 exec, -1
    ds_write_b128 v36, v[112:115]
    ds_read_b64_tr_b16 v[68:69], v37
    ds_read_b64_tr_b16 v[70:71], v38
    ds_read_b128 v[6:9], v39 offset:0
    v_mfma_f32_16x16x32_bf16 v[76:79], v[40:43], v[112:115], v[48:51]
    v_mfma_f32_16x16x32_bf16 v[80:83], v[44:47], v[112:115], v[52:55]
L_loop_ml:
    s_add_u32 s29, s29, 1
    s_add_u32 s37, s29, 3
    s_cmp_lt_u32 s37, s53
    s_cselect_b64 s[30:31], -1, 1
    ds_read_u8 v102, v34 offset:960
    s_nop 1
    v_exp_f32 v76, v76
    v_exp_f32 v77, v77
    v_exp_f32 v78, v78
    v_exp_f32 v79, v79
    v_mul_f32 v104, v104, v10
    v_mul_f32 v105, v105, v11
    v_mul_f32 v106, v106, v12
    v_mul_f32 v107, v107, v13
    v_cvt_pk_bf16_f32 v100, v104, v105
    v_cvt_pk_bf16_f32 v101, v106, v107
    v_exp_f32 v80, v80
    v_exp_f32 v81, v81
    v_exp_f32 v82, v82
    v_exp_f32 v83, v83
    v_mfma_f32_16x16x16_bf16 v[56:59], v[100:101], v[108:109], v[56:59]
    v_mfma_f32_16x16x16_bf16 v[60:63], v[100:101], v[110:111], v[60:63]
    v_add_f32 v76, 1.0, v76
    v_add_f32 v77, 1.0, v77
    v_add_f32 v78, 1.0, v78
    v_add_f32 v79, 1.0, v79
    v_add_f32 v80, 1.0, v80
    v_add_f32 v81, 1.0, v81
    v_add_f32 v82, 1.0, v82
    v_add_f32 v83, 1.0, v83
    v_rcp_f32 v76, v76
    v_rcp_f32 v77, v77
    v_rcp_f32 v78, v78
    v_rcp_f32 v79, v79
    v_rcp_f32 v80, v80
    v_rcp_f32 v81, v81
    v_rcp_f32 v82, v82
    v_rcp_f32 v83, v83
    v_cvt_pk_bf16_f32 v92, v76, v77
    v_cvt_pk_bf16_f32 v93, v78, v79
    v_cvt_pk_bf16_f32 v94, v80, v81
    v_cvt_pk_bf16_f32 v95, v82, v83
    s_cmp_ge_u32 s29, s53
    s_nop 0
    v_mfma_f32_16x16x32_bf16 v[104:107], v[92:95], v[24:27], v[20:23]
    s_cbranch_scc1 L_flush0_ml
    s_waitcnt vmcnt(2) lgkmcnt(0)
    v_lshl_or_b32 v102, v102, 6, v35
    s_mov_b64 exec, s[30:31]
    buffer_load_dwordx4 v[112:115], v102, s[20:23], 0 offen nt
    s_mov_b64 exec, -1
    ds_write_b128 v36, v[116:119]
    ds_read_b64_tr_b16 v[108:109], v37
    ds_read_b64_tr_b16 v[110:111], v38
    ds_read_b128 v[10:13], v39 offset:64
    v_mfma_f32_16x16x32_bf16 v[84:87], v[40:43], v[116:119], v[48:51]
    v_mfma_f32_16x16x32_bf16 v[88:91], v[44:47], v[116:119], v[52:55]
    s_add_u32 s29, s29, 1
    s_add_u32 s37, s29, 3
    s_cmp_lt_u32 s37, s53
    s_cselect_b64 s[30:31], -1, 1
    ds_read_u8 v102, v34 offset:976
    s_nop 1
    v_exp_f32 v84, v84
    v_exp_f32 v85, v85
    v_exp_f32 v86, v86
    v_exp_f32 v87, v87
    v_mul_f32 v104, v104, v6
    v_mul_f32 v105, v105, v7
    v_mul_f32 v106, v106, v8
    v_mul_f32 v107, v107, v9
    v_cvt_pk_bf16_f32 v100, v104, v105
    v_cvt_pk_bf16_f32 v101, v106, v107
    v_exp_f32 v88, v88
    v_exp_f32 v89, v89
    v_exp_f32 v90, v90
    v_exp_f32 v91, v91
    v_mfma_f32_16x16x16_bf16 v[56:59], v[100:101], v[68:69], v[56:59]
    v_mfma_f32_16x16x16_bf16 v[60:63], v[100:101], v[70:71], v[60:63]
    v_add_f32 v84, 1.0, v84
    v_add_f32 v85, 1.0, v85
    v_add_f32 v86, 1.0, v86
    v_add_f32 v87, 1.0, v87
    v_add_f32 v88, 1.0, v88
    v_add_f32 v89, 1.0, v89
    v_add_f32 v90, 1.0, v90
    v_add_f32 v91, 1.0, v91
    v_rcp_f32 v84, v84
    v_rcp_f32 v85, v85
    v_rcp_f32 v86, v86
    v_rcp_f32 v87, v87
    v_rcp_f32 v88, v88
    v_rcp_f32 v89, v89
    v_rcp_f32 v90, v90
    v_rcp_f32 v91, v91
    v_cvt_pk_bf16_f32 v92, v84, v85
    v_cvt_pk_bf16_f32 v93, v86, v87
    v_cvt_pk_bf16_f32 v94, v88, v89
    v_cvt_pk_bf16_f32 v95, v90, v91
    s_cmp_ge_u32 s29, s53
    s_nop 0
    v_mfma_f32_16x16x32_bf16 v[104:107], v[92:95], v[24:27], v[20:23]
    s_cbranch_scc1 L_flush1_ml
    s_waitcnt vmcnt(2) lgkmcnt(0)
    v_lshl_or_b32 v102, v102, 6, v35
    s_mov_b64 exec, s[30:31]
    buffer_load_dwordx4 v[116:119], v102, s[20:23], 0 offen nt
    s_mov_b64 exec, -1
    ds_write_b128 v36, v[120:123]
    ds_read_b64_tr_b16 v[68:69], v37
    ds_read_b64_tr_b16 v[70:71], v38
    ds_read_b128 v[6:9], v39 offset:128
    v_mfma_f32_16x16x32_bf16 v[76:79], v[40:43], v[120:123], v[48:51]
    v_mfma_f32_16x16x32_bf16 v[80:83], v[44:47], v[120:123], v[52:55]
    s_add_u32 s29, s29, 1
    s_add_u32 s37, s29, 3
    s_cmp_lt_u32 s37, s53
    s_cselect_b64 s[30:31], -1, 1
    ds_read_u8 v102, v34 offset:992
    s_nop 1
    v_exp_f32 v76, v76
    v_exp_f32 v77, v77
    v_exp_f32 v78, v78
    v_exp_f32 v79, v79
    v_mul_f32 v104, v104, v10
    v_mul_f32 v105, v105, v11
    v_mul_f32 v106, v106, v12
    v_mul_f32 v107, v107, v13
    v_cvt_pk_bf16_f32 v100, v104, v105
    v_cvt_pk_bf16_f32 v101, v106, v107
    v_exp_f32 v80, v80
    v_exp_f32 v81, v81
    v_exp_f32 v82, v82
    v_exp_f32 v83, v83
    v_mfma_f32_16x16x16_bf16 v[56:59], v[100:101], v[108:109], v[56:59]
    v_mfma_f32_16x16x16_bf16 v[60:63], v[100:101], v[110:111], v[60:63]
    v_add_f32 v76, 1.0, v76
    v_add_f32 v77, 1.0, v77
    v_add_f32 v78, 1.0, v78
    v_add_f32 v79, 1.0, v79
    v_add_f32 v80, 1.0, v80
    v_add_f32 v81, 1.0, v81
    v_add_f32 v82, 1.0, v82
    v_add_f32 v83, 1.0, v83
    v_rcp_f32 v76, v76
    v_rcp_f32 v77, v77
    v_rcp_f32 v78, v78
    v_rcp_f32 v79, v79
    v_rcp_f32 v80, v80
    v_rcp_f32 v81, v81
    v_rcp_f32 v82, v82
    v_rcp_f32 v83, v83
    v_cvt_pk_bf16_f32 v92, v76, v77
    v_cvt_pk_bf16_f32 v93, v78, v79
    v_cvt_pk_bf16_f32 v94, v80, v81
    v_cvt_pk_bf16_f32 v95, v82, v83
    s_cmp_ge_u32 s29, s53
    s_nop 0
    v_mfma_f32_16x16x32_bf16 v[104:107], v[92:95], v[24:27], v[20:23]
    s_cbranch_scc1 L_flush0_ml
    s_waitcnt vmcnt(2) lgkmcnt(0)
    v_lshl_or_b32 v102, v102, 6, v35
    s_mov_b64 exec, s[30:31]
    buffer_load_dwordx4 v[120:123], v102, s[20:23], 0 offen nt
    s_mov_b64 exec, -1
    ds_write_b128 v36, v[124:127]
    ds_read_b64_tr_b16 v[108:109], v37
    ds_read_b64_tr_b16 v[110:111], v38
    ds_read_b128 v[10:13], v39 offset:192
    v_mfma_f32_16x16x32_bf16 v[84:87], v[40:43], v[124:127], v[48:51]
    v_mfma_f32_16x16x32_bf16 v[88:91], v[44:47], v[124:127], v[52:55]
    s_add_u32 s29, s29, 1
    s_add_u32 s37, s29, 3
    s_cmp_lt_u32 s37, s53
    s_cselect_b64 s[30:31], -1, 1
    ds_read_u8 v102, v34 offset:1008
    s_nop 1
    v_exp_f32 v84, v84
    v_exp_f32 v85, v85
    v_exp_f32 v86, v86
    v_exp_f32 v87, v87
    v_mul_f32 v104, v104, v6
    v_mul_f32 v105, v105, v7
    v_mul_f32 v106, v106, v8
    v_mul_f32 v107, v107, v9
    v_cvt_pk_bf16_f32 v100, v104, v105
    v_cvt_pk_bf16_f32 v101, v106, v107
    v_exp_f32 v88, v88
    v_exp_f32 v89, v89
    v_exp_f32 v90, v90
    v_exp_f32 v91, v91
    v_mfma_f32_16x16x16_bf16 v[56:59], v[100:101], v[68:69], v[56:59]
    v_mfma_f32_16x16x16_bf16 v[60:63], v[100:101], v[70:71], v[60:63]
    v_add_f32 v84, 1.0, v84
    v_add_f32 v85, 1.0, v85
    v_add_f32 v86, 1.0, v86
    v_add_f32 v87, 1.0, v87
    v_add_f32 v88, 1.0, v88
    v_add_f32 v89, 1.0, v89
    v_add_f32 v90, 1.0, v90
    v_add_f32 v91, 1.0, v91
    v_rcp_f32 v84, v84
    v_rcp_f32 v85, v85
    v_rcp_f32 v86, v86
    v_rcp_f32 v87, v87
    v_rcp_f32 v88, v88
    v_rcp_f32 v89, v89
    v_rcp_f32 v90, v90
    v_rcp_f32 v91, v91
    v_cvt_pk_bf16_f32 v92, v84, v85
    v_cvt_pk_bf16_f32 v93, v86, v87
    v_cvt_pk_bf16_f32 v94, v88, v89
    v_cvt_pk_bf16_f32 v95, v90, v91
    v_add_u32 v39, 256, v39
    s_cmp_ge_u32 s29, s53
    v_mfma_f32_16x16x32_bf16 v[104:107], v[92:95], v[24:27], v[20:23]
    s_cbranch_scc1 L_flush1_ml
    s_waitcnt vmcnt(2) lgkmcnt(0)
    v_lshl_or_b32 v102, v102, 6, v35
    s_mov_b64 exec, s[30:31]
    buffer_load_dwordx4 v[124:127], v102, s[20:23], 0 offen nt
    s_mov_b64 exec, -1
    v_add_u32 v34, 64, v34
    ds_write_b128 v36, v[112:115]
    ds_read_b64_tr_b16 v[68:69], v37
    ds_read_b64_tr_b16 v[70:71], v38
    ds_read_b128 v[6:9], v39 offset:0
    v_mfma_f32_16x16x32_bf16 v[76:79], v[40:43], v[112:115], v[48:51]
    v_mfma_f32_16x16x32_bf16 v[80:83], v[44:47], v[112:115], v[52:55]
    s_branch L_loop_ml
L_flush0_ml:
    s_waitcnt lgkmcnt(0)
    s_nop 5
    v_mul_f32 v104, v104, v6
    v_mul_f32 v105, v105, v7
    v_mul_f32 v106, v106, v8
    v_mul_f32 v107, v107, v9
    v_cvt_pk_bf16_f32 v100, v104, v105
    v_cvt_pk_bf16_f32 v101, v106, v107
    s_nop 1
    v_mfma_f32_16x16x16_bf16 v[56:59], v[100:101], v[68:69], v[56:59]
    v_mfma_f32_16x16x16_bf16 v[60:63], v[100:101], v[70:71], v[60:63]
    s_branch L_epi
L_flush1_ml:
    s_waitcnt lgkmcnt(0)
    s_nop 5
    v_mul_f32 v104, v104, v10
    v_mul_f32 v105, v105, v11
    v_mul_f32 v106, v106, v12
    v_mul_f32 v107, v107, v13
    v_cvt_pk_bf16_f32 v100, v104, v105
    v_cvt_pk_bf16_f32 v101, v106, v107
    s_nop 1
    v_mfma_f32_16x16x16_bf16 v[56:59], v[100:101], v[108:109], v[56:59]
    v_mfma_f32_16x16x16_bf16 v[60:63], v[100:101], v[110:111], v[60:63]
    s_branch L_epi
L_end:
    s_endpgm
.section .rodata,"a"
.p2align 6
.amdhsa_kernel standalone__sequential_behavior_din__recsys_kernel
  .amdhsa_next_free_vgpr 128
  .amdhsa_next_free_sgpr 73
  .amdhsa_accum_offset 128
  .amdhsa_group_segment_fixed_size 0
  .amdhsa_kernarg_size 80
  .amdhsa_user_sgpr_count 2
  .amdhsa_user_sgpr_kernarg_segment_ptr 1
  .amdhsa_system_sgpr_workgroup_id_x 1
.end_amdhsa_kernel
```
